```python
import torch

def _softmax(x, axis=-1):
    return torch.softmax(x, dim=axis)
def _gelu(x):
    return torch.nn.functional.gelu(x, approximate="tanh")
def _silu(x):
    return torch.nn.functional.silu(x)
def _sigmoid(x):
    return torch.sigmoid(x)
def _layernorm(x, axis=-1, eps=1e-5):
    m = x.mean(dim=axis, keepdim=True)
    v = x.var(dim=axis, keepdim=True, unbiased=False)
    return (x - m) / torch.sqrt(v + eps)
def _scatter_add(tgt, idx, src, axis=0):
    return tgt.clone().index_add_(axis, idx, src)
def _segment_sum(src, seg, n):
    out = torch.zeros((n,) + src.shape[1:], dtype=src.dtype)
    return out.index_add_(0, seg, src)
def _pad(x, pw):
    flat = tuple(v for pair in reversed(pw) for v in pair)
    return torch.nn.functional.pad(x, flat)

kernel_name = 'standalone__rmsnorm__sampling'

def setup_inputs():

    _w = (lambda a: (lambda t: t.to(torch.bfloat16) if t.is_floating_point() else t)(torch.as_tensor(a)))
    B, S, D = 512, 32, 640
    return {
        "x": _w((lambda *s: torch.randn(*s, dtype=torch.bfloat16) * 0.05)(B, S, D)),
        "g": _w((lambda *s: torch.randn(*s, dtype=torch.bfloat16) * 0.05)(D) + 1.0),
    }

def reference(x, g):
    rms = torch.sqrt((x * x).mean(axis=-1, keepdims=True) + 1e-6)
    return x / rms * g
```

```asm
; @launch grid=(512,1,1) block=(256,1,1) lds=0
.amdgcn_target "amdgcn-amd-amdhsa--gfx950"
.text
.globl standalone__rmsnorm__sampling_kernel
.p2align 8
.type standalone__rmsnorm__sampling_kernel,@function
standalone__rmsnorm__sampling_kernel:
  s_load_dwordx2 s[8:9], s[0:1], 0
  s_load_dwordx2 s[12:13], s[0:1], 8
  s_load_dwordx2 s[16:17], s[0:1], 16
  s_cmp_ge_u32 s2, 512
  s_cbranch_scc1 L_done
  v_and_b32 v2, 15, v0
  v_lshlrev_b32 v2, 4, v2
  v_lshrrev_b32 v3, 4, v0
  v_and_b32 v4, 3, v3
  v_lshrrev_b32 v3, 2, v3
  v_mul_u32_u24 v3, 10240, v3
  v_mul_u32_u24 v4, 1280, v4
  v_add3_u32 v1, v2, v3, v4
  s_mul_i32 s20, s2, 40960
  s_add_u32 s21, s20, 5120
  s_mov_b32 s10, 20971520
  s_mov_b32 s11, 0x00020000
  s_mov_b32 s14, 1280
  s_mov_b32 s15, 0x00020000
  s_mov_b32 s18, 20971520
  s_mov_b32 s19, 0x00020000
  s_mov_b32 s30, 0x3acccccd
  s_mov_b32 s31, 0x358637bd
  v_mov_b32 v110, s31
  s_waitcnt lgkmcnt(0)
  buffer_load_dwordx4 v[48:51], v2, s[12:15], 0 offen offset:0
  buffer_load_dwordx4 v[52:55], v2, s[12:15], 0 offen offset:256
  buffer_load_dwordx4 v[56:59], v2, s[12:15], 0 offen offset:512
  buffer_load_dwordx4 v[60:63], v2, s[12:15], 0 offen offset:768
  buffer_load_dwordx4 v[64:67], v2, s[12:15], 0 offen offset:1024
  buffer_load_dwordx4 v[8:11], v1, s[8:11], s20 offen offset:0
  buffer_load_dwordx4 v[12:15], v1, s[8:11], s20 offen offset:256
  buffer_load_dwordx4 v[16:19], v1, s[8:11], s20 offen offset:512
  buffer_load_dwordx4 v[20:23], v1, s[8:11], s20 offen offset:768
  buffer_load_dwordx4 v[24:27], v1, s[8:11], s20 offen offset:1024
  buffer_load_dwordx4 v[28:31], v1, s[8:11], s21 offen offset:0
  buffer_load_dwordx4 v[32:35], v1, s[8:11], s21 offen offset:256
  buffer_load_dwordx4 v[36:39], v1, s[8:11], s21 offen offset:512
  buffer_load_dwordx4 v[40:43], v1, s[8:11], s21 offen offset:768
  buffer_load_dwordx4 v[44:47], v1, s[8:11], s21 offen offset:1024
  s_waitcnt vmcnt(10)
  v_lshlrev_b32 v68, 16, v48
  v_and_b32 v69, 0xffff0000, v48
  v_lshlrev_b32 v70, 16, v49
  v_and_b32 v71, 0xffff0000, v49
  v_lshlrev_b32 v72, 16, v50
  v_and_b32 v73, 0xffff0000, v50
  v_lshlrev_b32 v74, 16, v51
  v_and_b32 v75, 0xffff0000, v51
  v_lshlrev_b32 v76, 16, v52
  v_and_b32 v77, 0xffff0000, v52
  v_lshlrev_b32 v78, 16, v53
  v_and_b32 v79, 0xffff0000, v53
  v_lshlrev_b32 v80, 16, v54
  v_and_b32 v81, 0xffff0000, v54
  v_lshlrev_b32 v82, 16, v55
  v_and_b32 v83, 0xffff0000, v55
  v_lshlrev_b32 v84, 16, v56
  v_and_b32 v85, 0xffff0000, v56
  v_lshlrev_b32 v86, 16, v57
  v_and_b32 v87, 0xffff0000, v57
  v_lshlrev_b32 v88, 16, v58
  v_and_b32 v89, 0xffff0000, v58
  v_lshlrev_b32 v90, 16, v59
  v_and_b32 v91, 0xffff0000, v59
  v_lshlrev_b32 v92, 16, v60
  v_and_b32 v93, 0xffff0000, v60
  v_lshlrev_b32 v94, 16, v61
  v_and_b32 v95, 0xffff0000, v61
  v_lshlrev_b32 v96, 16, v62
  v_and_b32 v97, 0xffff0000, v62
  v_lshlrev_b32 v98, 16, v63
  v_and_b32 v99, 0xffff0000, v63
  v_lshlrev_b32 v100, 16, v64
  v_and_b32 v101, 0xffff0000, v64
  v_lshlrev_b32 v102, 16, v65
  v_and_b32 v103, 0xffff0000, v65
  v_lshlrev_b32 v104, 16, v66
  v_and_b32 v105, 0xffff0000, v66
  v_lshlrev_b32 v106, 16, v67
  v_and_b32 v107, 0xffff0000, v67
  v_mov_b32 v108, 0
  v_mov_b32 v109, 0
  s_waitcnt vmcnt(9)
  v_dot2c_f32_bf16 v108, v8, v8
  v_dot2c_f32_bf16 v109, v9, v9
  v_dot2c_f32_bf16 v108, v10, v10
  v_dot2c_f32_bf16 v109, v11, v11
  s_waitcnt vmcnt(8)
  v_dot2c_f32_bf16 v108, v12, v12
  v_dot2c_f32_bf16 v109, v13, v13
  v_dot2c_f32_bf16 v108, v14, v14
  v_dot2c_f32_bf16 v109, v15, v15
  s_waitcnt vmcnt(7)
  v_dot2c_f32_bf16 v108, v16, v16
  v_dot2c_f32_bf16 v109, v17, v17
  v_dot2c_f32_bf16 v108, v18, v18
  v_dot2c_f32_bf16 v109, v19, v19
  s_waitcnt vmcnt(6)
  v_dot2c_f32_bf16 v108, v20, v20
  v_dot2c_f32_bf16 v109, v21, v21
  v_dot2c_f32_bf16 v108, v22, v22
  v_dot2c_f32_bf16 v109, v23, v23
  s_waitcnt vmcnt(5)
  v_dot2c_f32_bf16 v108, v24, v24
  v_dot2c_f32_bf16 v109, v25, v25
  v_dot2c_f32_bf16 v108, v26, v26
  v_dot2c_f32_bf16 v109, v27, v27
  s_nop 2
  v_add_f32 v108, v108, v109
  s_nop 1
  v_add_f32_dpp v108, v108, v108 quad_perm:[1,0,3,2] row_mask:0xf bank_mask:0xf
  s_nop 1
  v_add_f32_dpp v108, v108, v108 quad_perm:[2,3,0,1] row_mask:0xf bank_mask:0xf
  s_nop 1
  v_add_f32_dpp v108, v108, v108 row_half_mirror row_mask:0xf bank_mask:0xf
  s_nop 1
  v_add_f32_dpp v108, v108, v108 row_mirror row_mask:0xf bank_mask:0xf
  v_fma_f32 v108, v108, s30, v110
  v_rsq_f32 v108, v108
  s_nop 0
  v_lshlrev_b32 v112, 16, v8
  v_and_b32 v113, 0xffff0000, v8
  v_pk_mul_f32 v[112:113], v[112:113], v[108:109] op_sel_hi:[1,0]
  v_pk_mul_f32 v[112:113], v[112:113], v[68:69]
  v_cvt_pk_bf16_f32 v8, v112, v113
  v_lshlrev_b32 v114, 16, v9
  v_and_b32 v115, 0xffff0000, v9
  v_pk_mul_f32 v[114:115], v[114:115], v[108:109] op_sel_hi:[1,0]
  v_pk_mul_f32 v[114:115], v[114:115], v[70:71]
  v_cvt_pk_bf16_f32 v9, v114, v115
  v_lshlrev_b32 v116, 16, v10
  v_and_b32 v117, 0xffff0000, v10
  v_pk_mul_f32 v[116:117], v[116:117], v[108:109] op_sel_hi:[1,0]
  v_pk_mul_f32 v[116:117], v[116:117], v[72:73]
  v_cvt_pk_bf16_f32 v10, v116, v117
  v_lshlrev_b32 v118, 16, v11
  v_and_b32 v119, 0xffff0000, v11
  v_pk_mul_f32 v[118:119], v[118:119], v[108:109] op_sel_hi:[1,0]
  v_pk_mul_f32 v[118:119], v[118:119], v[74:75]
  v_cvt_pk_bf16_f32 v11, v118, v119
  buffer_store_dwordx4 v[8:11], v1, s[16:19], s20 offen offset:0
  v_lshlrev_b32 v112, 16, v12
  v_and_b32 v113, 0xffff0000, v12
  v_pk_mul_f32 v[112:113], v[112:113], v[108:109] op_sel_hi:[1,0]
  v_pk_mul_f32 v[112:113], v[112:113], v[76:77]
  v_cvt_pk_bf16_f32 v12, v112, v113
  v_lshlrev_b32 v114, 16, v13
  v_and_b32 v115, 0xffff0000, v13
  v_pk_mul_f32 v[114:115], v[114:115], v[108:109] op_sel_hi:[1,0]
  v_pk_mul_f32 v[114:115], v[114:115], v[78:79]
  v_cvt_pk_bf16_f32 v13, v114, v115
  v_lshlrev_b32 v116, 16, v14
  v_and_b32 v117, 0xffff0000, v14
  v_pk_mul_f32 v[116:117], v[116:117], v[108:109] op_sel_hi:[1,0]
  v_pk_mul_f32 v[116:117], v[116:117], v[80:81]
  v_cvt_pk_bf16_f32 v14, v116, v117
  v_lshlrev_b32 v118, 16, v15
  v_and_b32 v119, 0xffff0000, v15
  v_pk_mul_f32 v[118:119], v[118:119], v[108:109] op_sel_hi:[1,0]
  v_pk_mul_f32 v[118:119], v[118:119], v[82:83]
  v_cvt_pk_bf16_f32 v15, v118, v119
  buffer_store_dwordx4 v[12:15], v1, s[16:19], s20 offen offset:256
  v_lshlrev_b32 v112, 16, v16
  v_and_b32 v113, 0xffff0000, v16
  v_pk_mul_f32 v[112:113], v[112:113], v[108:109] op_sel_hi:[1,0]
  v_pk_mul_f32 v[112:113], v[112:113], v[84:85]
  v_cvt_pk_bf16_f32 v16, v112, v113
  v_lshlrev_b32 v114, 16, v17
  v_and_b32 v115, 0xffff0000, v17
  v_pk_mul_f32 v[114:115], v[114:115], v[108:109] op_sel_hi:[1,0]
  v_pk_mul_f32 v[114:115], v[114:115], v[86:87]
  v_cvt_pk_bf16_f32 v17, v114, v115
  v_lshlrev_b32 v116, 16, v18
  v_and_b32 v117, 0xffff0000, v18
  v_pk_mul_f32 v[116:117], v[116:117], v[108:109] op_sel_hi:[1,0]
  v_pk_mul_f32 v[116:117], v[116:117], v[88:89]
  v_cvt_pk_bf16_f32 v18, v116, v117
  v_lshlrev_b32 v118, 16, v19
  v_and_b32 v119, 0xffff0000, v19
  v_pk_mul_f32 v[118:119], v[118:119], v[108:109] op_sel_hi:[1,0]
  v_pk_mul_f32 v[118:119], v[118:119], v[90:91]
  v_cvt_pk_bf16_f32 v19, v118, v119
  buffer_store_dwordx4 v[16:19], v1, s[16:19], s20 offen offset:512
  v_lshlrev_b32 v112, 16, v20
  v_and_b32 v113, 0xffff0000, v20
  v_pk_mul_f32 v[112:113], v[112:113], v[108:109] op_sel_hi:[1,0]
  v_pk_mul_f32 v[112:113], v[112:113], v[92:93]
  v_cvt_pk_bf16_f32 v20, v112, v113
  v_lshlrev_b32 v114, 16, v21
  v_and_b32 v115, 0xffff0000, v21
  v_pk_mul_f32 v[114:115], v[114:115], v[108:109] op_sel_hi:[1,0]
  v_pk_mul_f32 v[114:115], v[114:115], v[94:95]
  v_cvt_pk_bf16_f32 v21, v114, v115
  v_lshlrev_b32 v116, 16, v22
  v_and_b32 v117, 0xffff0000, v22
  v_pk_mul_f32 v[116:117], v[116:117], v[108:109] op_sel_hi:[1,0]
  v_pk_mul_f32 v[116:117], v[116:117], v[96:97]
  v_cvt_pk_bf16_f32 v22, v116, v117
  v_lshlrev_b32 v118, 16, v23
  v_and_b32 v119, 0xffff0000, v23
  v_pk_mul_f32 v[118:119], v[118:119], v[108:109] op_sel_hi:[1,0]
  v_pk_mul_f32 v[118:119], v[118:119], v[98:99]
  v_cvt_pk_bf16_f32 v23, v118, v119
  buffer_store_dwordx4 v[20:23], v1, s[16:19], s20 offen offset:768
  v_lshlrev_b32 v112, 16, v24
  v_and_b32 v113, 0xffff0000, v24
  v_pk_mul_f32 v[112:113], v[112:113], v[108:109] op_sel_hi:[1,0]
  v_pk_mul_f32 v[112:113], v[112:113], v[100:101]
  v_cvt_pk_bf16_f32 v24, v112, v113
  v_lshlrev_b32 v114, 16, v25
  v_and_b32 v115, 0xffff0000, v25
  v_pk_mul_f32 v[114:115], v[114:115], v[108:109] op_sel_hi:[1,0]
  v_pk_mul_f32 v[114:115], v[114:115], v[102:103]
  v_cvt_pk_bf16_f32 v25, v114, v115
  v_lshlrev_b32 v116, 16, v26
  v_and_b32 v117, 0xffff0000, v26
  v_pk_mul_f32 v[116:117], v[116:117], v[108:109] op_sel_hi:[1,0]
  v_pk_mul_f32 v[116:117], v[116:117], v[104:105]
  v_cvt_pk_bf16_f32 v26, v116, v117
  v_lshlrev_b32 v118, 16, v27
  v_and_b32 v119, 0xffff0000, v27
  v_pk_mul_f32 v[118:119], v[118:119], v[108:109] op_sel_hi:[1,0]
  v_pk_mul_f32 v[118:119], v[118:119], v[106:107]
  v_cvt_pk_bf16_f32 v27, v118, v119
  buffer_store_dwordx4 v[24:27], v1, s[16:19], s20 offen offset:1024
  v_mov_b32 v108, 0
  v_mov_b32 v109, 0
  s_waitcnt vmcnt(9)
  v_dot2c_f32_bf16 v108, v28, v28
  v_dot2c_f32_bf16 v109, v29, v29
  v_dot2c_f32_bf16 v108, v30, v30
  v_dot2c_f32_bf16 v109, v31, v31
  s_waitcnt vmcnt(8)
  v_dot2c_f32_bf16 v108, v32, v32
  v_dot2c_f32_bf16 v109, v33, v33
  v_dot2c_f32_bf16 v108, v34, v34
  v_dot2c_f32_bf16 v109, v35, v35
  s_waitcnt vmcnt(7)
  v_dot2c_f32_bf16 v108, v36, v36
  v_dot2c_f32_bf16 v109, v37, v37
  v_dot2c_f32_bf16 v108, v38, v38
  v_dot2c_f32_bf16 v109, v39, v39
  s_waitcnt vmcnt(6)
  v_dot2c_f32_bf16 v108, v40, v40
  v_dot2c_f32_bf16 v109, v41, v41
  v_dot2c_f32_bf16 v108, v42, v42
  v_dot2c_f32_bf16 v109, v43, v43
  s_waitcnt vmcnt(5)
  v_dot2c_f32_bf16 v108, v44, v44
  v_dot2c_f32_bf16 v109, v45, v45
  v_dot2c_f32_bf16 v108, v46, v46
  v_dot2c_f32_bf16 v109, v47, v47
  s_nop 2
  v_add_f32 v108, v108, v109
  s_nop 1
  v_add_f32_dpp v108, v108, v108 quad_perm:[1,0,3,2] row_mask:0xf bank_mask:0xf
  s_nop 1
  v_add_f32_dpp v108, v108, v108 quad_perm:[2,3,0,1] row_mask:0xf bank_mask:0xf
  s_nop 1
  v_add_f32_dpp v108, v108, v108 row_half_mirror row_mask:0xf bank_mask:0xf
  s_nop 1
  v_add_f32_dpp v108, v108, v108 row_mirror row_mask:0xf bank_mask:0xf
  v_fma_f32 v108, v108, s30, v110
  v_rsq_f32 v108, v108
  s_nop 0
  v_lshlrev_b32 v112, 16, v28
  v_and_b32 v113, 0xffff0000, v28
  v_pk_mul_f32 v[112:113], v[112:113], v[108:109] op_sel_hi:[1,0]
  v_pk_mul_f32 v[112:113], v[112:113], v[68:69]
  v_cvt_pk_bf16_f32 v28, v112, v113
  v_lshlrev_b32 v114, 16, v29
  v_and_b32 v115, 0xffff0000, v29
  v_pk_mul_f32 v[114:115], v[114:115], v[108:109] op_sel_hi:[1,0]
  v_pk_mul_f32 v[114:115], v[114:115], v[70:71]
  v_cvt_pk_bf16_f32 v29, v114, v115
  v_lshlrev_b32 v116, 16, v30
  v_and_b32 v117, 0xffff0000, v30
  v_pk_mul_f32 v[116:117], v[116:117], v[108:109] op_sel_hi:[1,0]
  v_pk_mul_f32 v[116:117], v[116:117], v[72:73]
  v_cvt_pk_bf16_f32 v30, v116, v117
  v_lshlrev_b32 v118, 16, v31
  v_and_b32 v119, 0xffff0000, v31
  v_pk_mul_f32 v[118:119], v[118:119], v[108:109] op_sel_hi:[1,0]
  v_pk_mul_f32 v[118:119], v[118:119], v[74:75]
  v_cvt_pk_bf16_f32 v31, v118, v119
  buffer_store_dwordx4 v[28:31], v1, s[16:19], s21 offen offset:0
  v_lshlrev_b32 v112, 16, v32
  v_and_b32 v113, 0xffff0000, v32
  v_pk_mul_f32 v[112:113], v[112:113], v[108:109] op_sel_hi:[1,0]
  v_pk_mul_f32 v[112:113], v[112:113], v[76:77]
  v_cvt_pk_bf16_f32 v32, v112, v113
  v_lshlrev_b32 v114, 16, v33
  v_and_b32 v115, 0xffff0000, v33
  v_pk_mul_f32 v[114:115], v[114:115], v[108:109] op_sel_hi:[1,0]
  v_pk_mul_f32 v[114:115], v[114:115], v[78:79]
  v_cvt_pk_bf16_f32 v33, v114, v115
  v_lshlrev_b32 v116, 16, v34
  v_and_b32 v117, 0xffff0000, v34
  v_pk_mul_f32 v[116:117], v[116:117], v[108:109] op_sel_hi:[1,0]
  v_pk_mul_f32 v[116:117], v[116:117], v[80:81]
  v_cvt_pk_bf16_f32 v34, v116, v117
  v_lshlrev_b32 v118, 16, v35
  v_and_b32 v119, 0xffff0000, v35
  v_pk_mul_f32 v[118:119], v[118:119], v[108:109] op_sel_hi:[1,0]
  v_pk_mul_f32 v[118:119], v[118:119], v[82:83]
  v_cvt_pk_bf16_f32 v35, v118, v119
  buffer_store_dwordx4 v[32:35], v1, s[16:19], s21 offen offset:256
  v_lshlrev_b32 v112, 16, v36
  v_and_b32 v113, 0xffff0000, v36
  v_pk_mul_f32 v[112:113], v[112:113], v[108:109] op_sel_hi:[1,0]
  v_pk_mul_f32 v[112:113], v[112:113], v[84:85]
  v_cvt_pk_bf16_f32 v36, v112, v113
  v_lshlrev_b32 v114, 16, v37
  v_and_b32 v115, 0xffff0000, v37
  v_pk_mul_f32 v[114:115], v[114:115], v[108:109] op_sel_hi:[1,0]
  v_pk_mul_f32 v[114:115], v[114:115], v[86:87]
  v_cvt_pk_bf16_f32 v37, v114, v115
  v_lshlrev_b32 v116, 16, v38
  v_and_b32 v117, 0xffff0000, v38
  v_pk_mul_f32 v[116:117], v[116:117], v[108:109] op_sel_hi:[1,0]
  v_pk_mul_f32 v[116:117], v[116:117], v[88:89]
  v_cvt_pk_bf16_f32 v38, v116, v117
  v_lshlrev_b32 v118, 16, v39
  v_and_b32 v119, 0xffff0000, v39
  v_pk_mul_f32 v[118:119], v[118:119], v[108:109] op_sel_hi:[1,0]
  v_pk_mul_f32 v[118:119], v[118:119], v[90:91]
  v_cvt_pk_bf16_f32 v39, v118, v119
  buffer_store_dwordx4 v[36:39], v1, s[16:19], s21 offen offset:512
  v_lshlrev_b32 v112, 16, v40
  v_and_b32 v113, 0xffff0000, v40
  v_pk_mul_f32 v[112:113], v[112:113], v[108:109] op_sel_hi:[1,0]
  v_pk_mul_f32 v[112:113], v[112:113], v[92:93]
  v_cvt_pk_bf16_f32 v40, v112, v113
  v_lshlrev_b32 v114, 16, v41
  v_and_b32 v115, 0xffff0000, v41
  v_pk_mul_f32 v[114:115], v[114:115], v[108:109] op_sel_hi:[1,0]
  v_pk_mul_f32 v[114:115], v[114:115], v[94:95]
  v_cvt_pk_bf16_f32 v41, v114, v115
  v_lshlrev_b32 v116, 16, v42
  v_and_b32 v117, 0xffff0000, v42
  v_pk_mul_f32 v[116:117], v[116:117], v[108:109] op_sel_hi:[1,0]
  v_pk_mul_f32 v[116:117], v[116:117], v[96:97]
  v_cvt_pk_bf16_f32 v42, v116, v117
  v_lshlrev_b32 v118, 16, v43
  v_and_b32 v119, 0xffff0000, v43
  v_pk_mul_f32 v[118:119], v[118:119], v[108:109] op_sel_hi:[1,0]
  v_pk_mul_f32 v[118:119], v[118:119], v[98:99]
  v_cvt_pk_bf16_f32 v43, v118, v119
  buffer_store_dwordx4 v[40:43], v1, s[16:19], s21 offen offset:768
  v_lshlrev_b32 v112, 16, v44
  v_and_b32 v113, 0xffff0000, v44
  v_pk_mul_f32 v[112:113], v[112:113], v[108:109] op_sel_hi:[1,0]
  v_pk_mul_f32 v[112:113], v[112:113], v[100:101]
  v_cvt_pk_bf16_f32 v44, v112, v113
  v_lshlrev_b32 v114, 16, v45
  v_and_b32 v115, 0xffff0000, v45
  v_pk_mul_f32 v[114:115], v[114:115], v[108:109] op_sel_hi:[1,0]
  v_pk_mul_f32 v[114:115], v[114:115], v[102:103]
  v_cvt_pk_bf16_f32 v45, v114, v115
  v_lshlrev_b32 v116, 16, v46
  v_and_b32 v117, 0xffff0000, v46
  v_pk_mul_f32 v[116:117], v[116:117], v[108:109] op_sel_hi:[1,0]
  v_pk_mul_f32 v[116:117], v[116:117], v[104:105]
  v_cvt_pk_bf16_f32 v46, v116, v117
  v_lshlrev_b32 v118, 16, v47
  v_and_b32 v119, 0xffff0000, v47
  v_pk_mul_f32 v[118:119], v[118:119], v[108:109] op_sel_hi:[1,0]
  v_pk_mul_f32 v[118:119], v[118:119], v[106:107]
  v_cvt_pk_bf16_f32 v47, v118, v119
  buffer_store_dwordx4 v[44:47], v1, s[16:19], s21 offen offset:1024
L_done:
  s_endpgm
.section .rodata,"a"
.p2align 6
.amdhsa_kernel standalone__rmsnorm__sampling_kernel
  .amdhsa_next_free_vgpr 120
  .amdhsa_next_free_sgpr 40
  .amdhsa_accum_offset 120
  .amdhsa_group_segment_fixed_size 0
  .amdhsa_kernarg_size 40
  .amdhsa_user_sgpr_count 2
  .amdhsa_user_sgpr_kernarg_segment_ptr 1
  .amdhsa_system_sgpr_workgroup_id_x 1
.end_amdhsa_kernel
```
